```python
import torch

def _softmax(x, axis=-1):
    return torch.softmax(x, dim=axis)
def _gelu(x):
    return torch.nn.functional.gelu(x, approximate="tanh")
def _silu(x):
    return torch.nn.functional.silu(x)
def _sigmoid(x):
    return torch.sigmoid(x)
def _layernorm(x, axis=-1, eps=1e-5):
    m = x.mean(dim=axis, keepdim=True)
    v = x.var(dim=axis, keepdim=True, unbiased=False)
    return (x - m) / torch.sqrt(v + eps)
def _scatter_add(tgt, idx, src, axis=0):
    return tgt.clone().index_add_(axis, idx, src)
def _segment_sum(src, seg, n):
    out = torch.zeros((n,) + src.shape[1:], dtype=src.dtype)
    return out.index_add_(0, seg, src)
def _pad(x, pw):
    flat = tuple(v for pair in reversed(pw) for v in pair)
    return torch.nn.functional.pad(x, flat)

kernel_name = 'standalone__gqa_softmax__sampling'

def setup_inputs():

    _w = (lambda a: (lambda t: t.to(torch.bfloat16) if t.is_floating_point() else t)(torch.as_tensor(a)))
    B, Hq, Hkv, Sq, Sk, D = 8, 32, 8, 1, 2048, 128
    return {
        "q": _w((lambda *s: torch.randn(*s, dtype=torch.bfloat16) * 0.8)(B, Hq, Sq, D)),
        "k": _w((lambda *s: torch.randn(*s, dtype=torch.bfloat16) * 0.8)(B, Hkv, Sk, D)),
        "v": _w((lambda *s: torch.randn(*s, dtype=torch.bfloat16) * 0.05)(B, Hkv, Sk, D)),
    }

def reference(q, k, v):
    B, Hq, Sq, D = q.shape
    Hkv = k.shape[1]
    rep = Hq // Hkv
    k = (lambda x, n, axis: torch.repeat_interleave(x, n, dim=axis))(k, rep, axis=1)
    v = (lambda x, n, axis: torch.repeat_interleave(x, n, dim=axis))(v, rep, axis=1)
    scale = D ** -0.5
    scores = torch.einsum("bhqd,bhkd->bhqk", q, k) * scale
    p = _softmax(scores, axis=-1)
    return torch.einsum("bhqk,bhkd->bhqd", p, v)
```

```asm
; @launch grid=(256,1,1) block=(320,1,1) lds=8320
.amdgcn_target "amdgcn-amd-amdhsa--gfx950"
.text
.p2align 12
.globl standalone__gqa_softmax__sampling_kernel
.p2align 8
.type standalone__gqa_softmax__sampling_kernel,@function
standalone__gqa_softmax__sampling_kernel:
  s_load_dwordx2 s[8:9], s[0:1], 8
  s_load_dwordx2 s[4:5], s[0:1], 0
  s_load_dwordx2 s[12:13], s[0:1], 16
  s_cmp_ge_u32 s2, 0x100
  s_cbranch_scc1 L_end
  v_cmp_lt_u32 vcc, 0xff, v0
  s_and_b32 s32, s2, 63
  s_lshr_b32 s33, s2, 6
  s_cbranch_vccnz L_helper
  s_lshl_b32 s28, s32, 19
  s_lshl_b32 s3, s33, 17
  s_or_b32 s28, s28, s3
  s_and_b32 s3, s2, 56
  s_lshl_b32 s3, s3, 9
  s_or_b32 s28, s28, s3
  s_lshl_b32 s34, s32, 10
  s_lshl_b32 s6, 1, 16
  s_lshl_b32 s7, 1, 17
  s_lshl_b32 s10, 1, 25
  s_mov_b32 s11, s7
  s_mov_b32 s14, s10
  s_mov_b32 s15, s7
  v_and_b32 v1, 0xc3, v0
  v_lshlrev_b32 v1, 4, v1
  v_and_b32 v4, 12, v0
  v_lshl_or_b32 v1, v4, 6, v1
  v_and_b32 v4, 48, v0
  v_lshl_or_b32 v1, v4, 2, v1
  v_and_b32 v5, 3, v0
  v_lshlrev_b32 v3, 8, v5
  v_and_b32 v4, 60, v0
  v_lshl_or_b32 v3, v4, 2, v3
  v_lshlrev_b32 v2, 4, v0
  s_waitcnt lgkmcnt(0)
  buffer_load_dwordx4 v[8:11], v3, s[4:7], s34 offen
  buffer_load_dwordx4 v[144:147], v1, s[8:11], s28 offen nt
  s_xor_b32 s41, s28, 0x1000
  buffer_load_dwordx4 v[148:151], v1, s[8:11], s41 offen nt
  s_xor_b32 s42, s28, 0x2000
  buffer_load_dwordx4 v[152:155], v1, s[8:11], s42 offen nt
  s_xor_b32 s43, s28, 0x3000
  buffer_load_dwordx4 v[156:159], v1, s[8:11], s43 offen nt
  s_xor_b32 s40, s28, 0x4000
  buffer_load_dwordx4 v[160:163], v1, s[8:11], s40 offen nt
  s_xor_b32 s41, s28, 0x5000
  buffer_load_dwordx4 v[164:167], v1, s[8:11], s41 offen nt
  s_xor_b32 s42, s28, 0x6000
  buffer_load_dwordx4 v[168:171], v1, s[8:11], s42 offen nt
  s_xor_b32 s43, s28, 0x7000
  buffer_load_dwordx4 v[172:175], v1, s[8:11], s43 offen nt
  s_load_dwordx2 s[16:17], s[0:1], 24
  s_load_dwordx2 s[24:25], s[0:1], 40
  s_load_dwordx2 s[20:21], s[0:1], 32
  s_movk_i32 s22, 0x100
  s_mov_b32 s23, s7
  s_lshl_b32 s50, s32, 2
  s_cmp_eq_u32 s33, 3
  s_cselect_b32 s29, 0, 0x7ff00000
  s_cselect_b32 s30, 0x7ff00000, 0
  s_cselect_b32 s31, 0, 0x4210
  s_mov_b32 s18, s6
  s_mov_b32 s19, s7
  s_lshl_b32 s26, 1, 28
  s_mov_b32 s27, s7
  s_mov_b32 s35, 0x3e0293ee
  s_mov_b32 s36, 0x05040100
  s_mov_b32 s37, 0x07060302
  s_lshl_b32 s47, s32, 14
  s_add_u32 s47, s47, 0xfe00000
  s_lshl_b32 s3, s33, 12
  s_add_u32 s46, s47, s3
  s_add_u32 s48, s47, 0x1000
  s_add_u32 s49, s47, 0x2000
  s_getreg_b32 s52, hwreg(HW_REG_XCC_ID, 0, 4)
  s_or_b32 s52, s52, 16
  s_mul_i32 s55, s52, 0x421
  v_mov_b32 v80, 0
  v_mov_b32 v81, 0
  v_mov_b32 v82, 0
  v_mov_b32 v83, 0
  v_mov_b32 v84, 0
  v_mov_b32 v85, 0
  v_mov_b32 v86, 0
  v_mov_b32 v87, 0
  v_mov_b32 v88, 0
  v_mov_b32 v89, 0
  v_mov_b32 v90, 0
  v_mov_b32 v91, 0
  v_mov_b32 v92, 0
  v_mov_b32 v93, 0
  v_mov_b32 v94, 0
  v_mov_b32 v95, 0
  v_mov_b32 v96, 0
  v_mov_b32 v97, 0
  v_mov_b32 v98, 0
  v_mov_b32 v99, 0
  v_mov_b32 v100, 0
  v_mov_b32 v101, 0
  v_mov_b32 v102, 0
  v_mov_b32 v103, 0
  v_mov_b32 v104, 0
  v_mov_b32 v105, 0
  v_mov_b32 v106, 0
  v_mov_b32 v107, 0
  v_mov_b32 v108, 0
  v_mov_b32 v109, 0
  v_mov_b32 v110, 0
  v_mov_b32 v111, 0
  v_mov_b32 v112, 0
  v_mov_b32 v113, 0
  v_mov_b32 v114, 0
  v_mov_b32 v115, 0
  v_mov_b32 v116, 0
  v_mov_b32 v117, 0
  v_mov_b32 v118, 0
  v_mov_b32 v119, 0
  v_mov_b32 v120, 0
  v_mov_b32 v121, 0
  v_mov_b32 v122, 0
  v_mov_b32 v123, 0
  v_mov_b32 v124, 0
  v_mov_b32 v125, 0
  v_mov_b32 v126, 0
  v_mov_b32 v127, 0
  v_mov_b32 v128, 0
  v_mov_b32 v129, 0
  v_mov_b32 v130, 0
  v_mov_b32 v131, 0
  v_mov_b32 v132, 0
  v_mov_b32 v133, 0
  v_mov_b32 v134, 0
  v_mov_b32 v135, 0
  v_mov_b32 v136, 0
  v_mov_b32 v137, 0
  v_mov_b32 v138, 0
  v_mov_b32 v139, 0
  v_mov_b32 v140, 0
  v_mov_b32 v141, 0
  v_mov_b32 v142, 0
  v_mov_b32 v143, 0
  v_mov_b32 v184, 0
  v_mov_b32 v185, 0
  v_mov_b32 v186, 0
  v_mov_b32 v187, 0
  v_lshrrev_b32 v6, 6, v0
  v_lshlrev_b32 v3, 5, v5
  v_lshl_add_u32 v3, v6, 3, v3
  v_lshlrev_b32 v7, 5, v6
  s_waitcnt lgkmcnt(0)
  s_xor_b32 s40, s28, 0x8000
  buffer_load_dwordx4 v[176:179], v1, s[8:11], s40 offen nt
  s_waitcnt vmcnt(8)
  s_movk_i32 s56, 0x200
  v_mfma_f32_16x16x32_bf16 v[12:15], v[144:147], v[8:11], 0
  s_xor_b32 s41, s28, 0x9000
  buffer_load_dwordx4 v[180:183], v1, s[8:11], s41 offen nt
  s_waitcnt vmcnt(8)
  v_mfma_f32_16x16x32_bf16 v[16:19], v[148:151], v[8:11], 0
  s_xor_b32 s42, s28, 0xa000
  buffer_load_dwordx4 v[144:147], v1, s[8:11], s42 offen nt
  s_waitcnt vmcnt(8)
  v_mfma_f32_16x16x32_bf16 v[20:23], v[152:155], v[8:11], 0
  v_add_f32_dpp v28, v13, v12 row_ror:12 row_mask:0xf bank_mask:0x1
  s_nop 1
  v_add_f32_dpp v28, v14, v28 row_ror:8 row_mask:0xf bank_mask:0x1
  s_nop 1
  v_add_f32_dpp v28, v15, v28 row_ror:4 row_mask:0xf bank_mask:0x1
  s_xor_b32 s43, s28, 0xb000
  buffer_load_dwordx4 v[148:151], v1, s[8:11], s43 offen nt
  s_waitcnt vmcnt(8)
  v_mfma_f32_16x16x32_bf16 v[24:27], v[156:159], v[8:11], 0
  v_add_f32_dpp v29, v17, v16 row_ror:12 row_mask:0xf bank_mask:0x1
  s_nop 1
  v_add_f32_dpp v29, v18, v29 row_ror:8 row_mask:0xf bank_mask:0x1
  s_nop 1
  v_add_f32_dpp v29, v19, v29 row_ror:4 row_mask:0xf bank_mask:0x1
  s_xor_b32 s40, s28, 0xc000
  buffer_load_dwordx4 v[152:155], v1, s[8:11], s40 offen nt
  s_waitcnt vmcnt(8)
  v_mfma_f32_16x16x32_bf16 v[12:15], v[160:163], v[8:11], 0
  v_add_f32_dpp v28, v20, v21 row_ror:4 row_mask:0xf bank_mask:0x2
  s_nop 1
  v_add_f32_dpp v28, v22, v28 row_ror:12 row_mask:0xf bank_mask:0x2
  s_nop 1
  v_add_f32_dpp v28, v23, v28 row_ror:8 row_mask:0xf bank_mask:0x2
  s_xor_b32 s41, s28, 0xd000
  buffer_load_dwordx4 v[156:159], v1, s[8:11], s41 offen nt
  s_waitcnt vmcnt(8)
  v_mfma_f32_16x16x32_bf16 v[16:19], v[164:167], v[8:11], 0
  v_add_f32_dpp v29, v24, v25 row_ror:4 row_mask:0xf bank_mask:0x2
  s_nop 1
  v_add_f32_dpp v29, v26, v29 row_ror:12 row_mask:0xf bank_mask:0x2
  s_nop 1
  v_add_f32_dpp v29, v27, v29 row_ror:8 row_mask:0xf bank_mask:0x2
  s_xor_b32 s42, s28, 0xe000
  buffer_load_dwordx4 v[160:163], v1, s[8:11], s42 offen nt
  s_waitcnt vmcnt(8)
  v_mfma_f32_16x16x32_bf16 v[20:23], v[168:171], v[8:11], 0
  v_add_f32_dpp v28, v12, v14 row_ror:8 row_mask:0xf bank_mask:0x4
  s_nop 1
  v_add_f32_dpp v28, v13, v28 row_ror:4 row_mask:0xf bank_mask:0x4
  s_nop 1
  v_add_f32_dpp v28, v15, v28 row_ror:12 row_mask:0xf bank_mask:0x4
  s_xor_b32 s43, s28, 0xf000
  buffer_load_dwordx4 v[164:167], v1, s[8:11], s43 offen nt
  s_waitcnt vmcnt(8)
  v_mfma_f32_16x16x32_bf16 v[24:27], v[172:175], v[8:11], 0
  v_add_f32_dpp v29, v16, v18 row_ror:8 row_mask:0xf bank_mask:0x4
  s_nop 1
  v_add_f32_dpp v29, v17, v29 row_ror:4 row_mask:0xf bank_mask:0x4
  s_nop 1
  v_add_f32_dpp v29, v19, v29 row_ror:12 row_mask:0xf bank_mask:0x4
  s_xor_b32 s40, s28, 0x10000
  buffer_load_dwordx4 v[168:171], v1, s[8:11], s40 offen nt
  s_waitcnt vmcnt(8)
  v_mfma_f32_16x16x32_bf16 v[12:15], v[176:179], v[8:11], 0
  v_add_f32_dpp v28, v20, v23 row_ror:12 row_mask:0xf bank_mask:0x8
  s_nop 1
  v_add_f32_dpp v28, v21, v28 row_ror:8 row_mask:0xf bank_mask:0x8
  s_nop 1
  v_add_f32_dpp v28, v22, v28 row_ror:4 row_mask:0xf bank_mask:0x8
  s_xor_b32 s41, s28, 0x11000
  buffer_load_dwordx4 v[172:175], v1, s[8:11], s41 offen nt
  s_waitcnt vmcnt(8)
  v_mfma_f32_16x16x32_bf16 v[16:19], v[180:183], v[8:11], 0
  v_add_f32_dpp v29, v24, v27 row_ror:12 row_mask:0xf bank_mask:0x8
  s_nop 1
  v_add_f32_dpp v29, v25, v29 row_ror:8 row_mask:0xf bank_mask:0x8
  s_nop 1
  v_add_f32_dpp v29, v26, v29 row_ror:4 row_mask:0xf bank_mask:0x8
  s_xor_b32 s42, s28, 0x12000
  buffer_load_dwordx4 v[176:179], v1, s[8:11], s42 offen nt
  s_waitcnt vmcnt(8)
  v_mfma_f32_16x16x32_bf16 v[20:23], v[144:147], v[8:11], 0
  v_add_f32_dpp v30, v13, v12 row_ror:12 row_mask:0xf bank_mask:0x1
  s_nop 1
  v_add_f32_dpp v30, v14, v30 row_ror:8 row_mask:0xf bank_mask:0x1
  s_nop 1
  v_add_f32_dpp v30, v15, v30 row_ror:4 row_mask:0xf bank_mask:0x1
  s_xor_b32 s43, s28, 0x13000
  buffer_load_dwordx4 v[180:183], v1, s[8:11], s43 offen nt
  s_waitcnt vmcnt(8)
  v_mfma_f32_16x16x32_bf16 v[24:27], v[148:151], v[8:11], 0
  v_add_f32_dpp v31, v17, v16 row_ror:12 row_mask:0xf bank_mask:0x1
  s_nop 1
  v_add_f32_dpp v31, v18, v31 row_ror:8 row_mask:0xf bank_mask:0x1
  s_nop 1
  v_add_f32_dpp v31, v19, v31 row_ror:4 row_mask:0xf bank_mask:0x1
  s_xor_b32 s40, s28, 0x14000
  buffer_load_dwordx4 v[144:147], v1, s[8:11], s40 offen nt
  s_waitcnt vmcnt(8)
  v_mfma_f32_16x16x32_bf16 v[12:15], v[152:155], v[8:11], 0
  v_add_f32_dpp v30, v20, v21 row_ror:4 row_mask:0xf bank_mask:0x2
  s_nop 1
  v_add_f32_dpp v30, v22, v30 row_ror:12 row_mask:0xf bank_mask:0x2
  s_nop 1
  v_add_f32_dpp v30, v23, v30 row_ror:8 row_mask:0xf bank_mask:0x2
  s_xor_b32 s41, s28, 0x15000
  buffer_load_dwordx4 v[148:151], v1, s[8:11], s41 offen nt
  s_waitcnt vmcnt(8)
  v_mfma_f32_16x16x32_bf16 v[16:19], v[156:159], v[8:11], 0
  v_add_f32_dpp v31, v24, v25 row_ror:4 row_mask:0xf bank_mask:0x2
  s_nop 1
  v_add_f32_dpp v31, v26, v31 row_ror:12 row_mask:0xf bank_mask:0x2
  s_nop 1
  v_add_f32_dpp v31, v27, v31 row_ror:8 row_mask:0xf bank_mask:0x2
  s_xor_b32 s42, s28, 0x16000
  buffer_load_dwordx4 v[152:155], v1, s[8:11], s42 offen nt
  s_barrier
  s_waitcnt vmcnt(8)
  v_mfma_f32_16x16x32_bf16 v[20:23], v[160:163], v[8:11], 0
  v_add_f32_dpp v30, v12, v14 row_ror:8 row_mask:0xf bank_mask:0x4
  s_nop 1
  v_add_f32_dpp v30, v13, v30 row_ror:4 row_mask:0xf bank_mask:0x4
  s_nop 1
  v_add_f32_dpp v30, v15, v30 row_ror:12 row_mask:0xf bank_mask:0x4
  s_xor_b32 s43, s28, 0x17000
  buffer_load_dwordx4 v[156:159], v1, s[8:11], s43 offen nt
  s_waitcnt vmcnt(8)
  v_mfma_f32_16x16x32_bf16 v[24:27], v[164:167], v[8:11], 0
  v_add_f32_dpp v31, v16, v18 row_ror:8 row_mask:0xf bank_mask:0x4
  s_nop 1
  v_add_f32_dpp v31, v17, v31 row_ror:4 row_mask:0xf bank_mask:0x4
  s_nop 1
  v_add_f32_dpp v31, v19, v31 row_ror:12 row_mask:0xf bank_mask:0x4
  s_xor_b32 s40, s28, 0x18000
  buffer_load_dwordx4 v[160:163], v1, s[8:11], s40 offen nt
  s_waitcnt vmcnt(8)
  v_mfma_f32_16x16x32_bf16 v[12:15], v[168:171], v[8:11], 0
  v_add_f32_dpp v30, v20, v23 row_ror:12 row_mask:0xf bank_mask:0x8
  s_nop 1
  v_add_f32_dpp v30, v21, v30 row_ror:8 row_mask:0xf bank_mask:0x8
  s_nop 1
  v_add_f32_dpp v30, v22, v30 row_ror:4 row_mask:0xf bank_mask:0x8
  s_xor_b32 s41, s28, 0x19000
  buffer_load_dwordx4 v[164:167], v1, s[8:11], s41 offen nt
  s_waitcnt vmcnt(8)
  v_mfma_f32_16x16x32_bf16 v[16:19], v[172:175], v[8:11], 0
  v_add_f32_dpp v31, v24, v27 row_ror:12 row_mask:0xf bank_mask:0x8
  s_nop 1
  v_add_f32_dpp v31, v25, v31 row_ror:8 row_mask:0xf bank_mask:0x8
  s_nop 1
  v_add_f32_dpp v31, v26, v31 row_ror:4 row_mask:0xf bank_mask:0x8
  s_xor_b32 s42, s28, 0x1a000
  buffer_load_dwordx4 v[168:171], v1, s[8:11], s42 offen nt
  s_waitcnt vmcnt(8)
  v_mfma_f32_16x16x32_bf16 v[20:23], v[176:179], v[8:11], 0
  v_add_f32_dpp v32, v13, v12 row_ror:12 row_mask:0xf bank_mask:0x1
  s_nop 1
  v_add_f32_dpp v32, v14, v32 row_ror:8 row_mask:0xf bank_mask:0x1
  s_nop 1
  v_add_f32_dpp v32, v15, v32 row_ror:4 row_mask:0xf bank_mask:0x1
  s_xor_b32 s43, s28, 0x1b000
  buffer_load_dwordx4 v[172:175], v1, s[8:11], s43 offen nt
  s_waitcnt vmcnt(8)
  v_mfma_f32_16x16x32_bf16 v[24:27], v[180:183], v[8:11], 0
  v_add_f32_dpp v33, v17, v16 row_ror:12 row_mask:0xf bank_mask:0x1
  s_nop 1
  v_add_f32_dpp v33, v18, v33 row_ror:8 row_mask:0xf bank_mask:0x1
  s_nop 1
  v_add_f32_dpp v33, v19, v33 row_ror:4 row_mask:0xf bank_mask:0x1
  s_xor_b32 s40, s28, 0x1c000
  buffer_load_dwordx4 v[176:179], v1, s[8:11], s40 offen nt
  s_waitcnt vmcnt(8)
  v_mfma_f32_16x16x32_bf16 v[12:15], v[144:147], v[8:11], 0
  v_add_f32_dpp v32, v20, v21 row_ror:4 row_mask:0xf bank_mask:0x2
  s_nop 1
  v_add_f32_dpp v32, v22, v32 row_ror:12 row_mask:0xf bank_mask:0x2
  s_nop 1
  v_add_f32_dpp v32, v23, v32 row_ror:8 row_mask:0xf bank_mask:0x2
  s_xor_b32 s41, s28, 0x1d000
  buffer_load_dwordx4 v[180:183], v1, s[8:11], s41 offen nt
  s_waitcnt vmcnt(8)
  v_mfma_f32_16x16x32_bf16 v[16:19], v[148:151], v[8:11], 0
  v_add_f32_dpp v33, v24, v25 row_ror:4 row_mask:0xf bank_mask:0x2
  s_nop 1
  v_add_f32_dpp v33, v26, v33 row_ror:12 row_mask:0xf bank_mask:0x2
  s_nop 1
  v_add_f32_dpp v33, v27, v33 row_ror:8 row_mask:0xf bank_mask:0x2
  s_xor_b32 s42, s28, 0x1e000
  buffer_load_dwordx4 v[144:147], v1, s[8:11], s42 offen nt
  s_waitcnt vmcnt(8)
  v_mfma_f32_16x16x32_bf16 v[20:23], v[152:155], v[8:11], 0
  v_add_f32_dpp v32, v12, v14 row_ror:8 row_mask:0xf bank_mask:0x4
  s_nop 1
  v_add_f32_dpp v32, v13, v32 row_ror:4 row_mask:0xf bank_mask:0x4
  s_nop 1
  v_add_f32_dpp v32, v15, v32 row_ror:12 row_mask:0xf bank_mask:0x4
  s_xor_b32 s43, s28, 0x1f000
  buffer_load_dwordx4 v[148:151], v1, s[8:11], s43 offen nt
  s_waitcnt vmcnt(8)
  v_mfma_f32_16x16x32_bf16 v[24:27], v[156:159], v[8:11], 0
  v_add_f32_dpp v33, v16, v18 row_ror:8 row_mask:0xf bank_mask:0x4
  s_nop 1
  v_add_f32_dpp v33, v17, v33 row_ror:4 row_mask:0xf bank_mask:0x4
  s_nop 1
  v_add_f32_dpp v33, v19, v33 row_ror:12 row_mask:0xf bank_mask:0x4
  buffer_load_dwordx4 v[152:155], v2, s[12:15], s28 offen nt
  s_waitcnt vmcnt(8)
  v_mfma_f32_16x16x32_bf16 v[12:15], v[160:163], v[8:11], 0
  v_add_f32_dpp v32, v20, v23 row_ror:12 row_mask:0xf bank_mask:0x8
  s_nop 1
  v_add_f32_dpp v32, v21, v32 row_ror:8 row_mask:0xf bank_mask:0x8
  s_nop 1
  v_add_f32_dpp v32, v22, v32 row_ror:4 row_mask:0xf bank_mask:0x8
  s_xor_b32 s41, s28, 0x1000
  buffer_load_dwordx4 v[156:159], v2, s[12:15], s41 offen nt
  s_waitcnt vmcnt(8)
  v_mfma_f32_16x16x32_bf16 v[16:19], v[164:167], v[8:11], 0
  v_add_f32_dpp v33, v24, v27 row_ror:12 row_mask:0xf bank_mask:0x8
  s_nop 1
  v_add_f32_dpp v33, v25, v33 row_ror:8 row_mask:0xf bank_mask:0x8
  s_nop 1
  v_add_f32_dpp v33, v26, v33 row_ror:4 row_mask:0xf bank_mask:0x8
  s_xor_b32 s42, s28, 0x2000
  buffer_load_dwordx4 v[160:163], v2, s[12:15], s42 offen nt
  s_waitcnt vmcnt(8)
  v_mfma_f32_16x16x32_bf16 v[20:23], v[168:171], v[8:11], 0
  v_add_f32_dpp v34, v13, v12 row_ror:12 row_mask:0xf bank_mask:0x1
  s_nop 1
  v_add_f32_dpp v34, v14, v34 row_ror:8 row_mask:0xf bank_mask:0x1
  s_nop 1
  v_add_f32_dpp v34, v15, v34 row_ror:4 row_mask:0xf bank_mask:0x1
  s_xor_b32 s43, s28, 0x3000
  buffer_load_dwordx4 v[164:167], v2, s[12:15], s43 offen nt
  s_waitcnt vmcnt(8)
  v_mfma_f32_16x16x32_bf16 v[24:27], v[172:175], v[8:11], 0
  v_add_f32_dpp v35, v17, v16 row_ror:12 row_mask:0xf bank_mask:0x1
  s_nop 1
  v_add_f32_dpp v35, v18, v35 row_ror:8 row_mask:0xf bank_mask:0x1
  s_nop 1
  v_add_f32_dpp v35, v19, v35 row_ror:4 row_mask:0xf bank_mask:0x1
  s_xor_b32 s40, s28, 0x4000
  buffer_load_dwordx4 v[168:171], v2, s[12:15], s40 offen nt
  s_waitcnt vmcnt(8)
  v_mfma_f32_16x16x32_bf16 v[12:15], v[176:179], v[8:11], 0
  v_add_f32_dpp v34, v20, v21 row_ror:4 row_mask:0xf bank_mask:0x2
  s_nop 1
  v_add_f32_dpp v34, v22, v34 row_ror:12 row_mask:0xf bank_mask:0x2
  s_nop 1
  v_add_f32_dpp v34, v23, v34 row_ror:8 row_mask:0xf bank_mask:0x2
  s_xor_b32 s41, s28, 0x5000
  buffer_load_dwordx4 v[172:175], v2, s[12:15], s41 offen nt
  s_waitcnt vmcnt(8)
  v_mfma_f32_16x16x32_bf16 v[16:19], v[180:183], v[8:11], 0
  v_add_f32_dpp v35, v24, v25 row_ror:4 row_mask:0xf bank_mask:0x2
  s_nop 1
  v_add_f32_dpp v35, v26, v35 row_ror:12 row_mask:0xf bank_mask:0x2
  s_nop 1
  v_add_f32_dpp v35, v27, v35 row_ror:8 row_mask:0xf bank_mask:0x2
  s_xor_b32 s42, s28, 0x6000
  buffer_load_dwordx4 v[176:179], v2, s[12:15], s42 offen nt
  s_waitcnt vmcnt(8)
  v_mfma_f32_16x16x32_bf16 v[20:23], v[144:147], v[8:11], 0
  v_add_f32_dpp v34, v12, v14 row_ror:8 row_mask:0xf bank_mask:0x4
  s_nop 1
  v_add_f32_dpp v34, v13, v34 row_ror:4 row_mask:0xf bank_mask:0x4
  s_nop 1
  v_add_f32_dpp v34, v15, v34 row_ror:12 row_mask:0xf bank_mask:0x4
  s_xor_b32 s43, s28, 0x7000
  buffer_load_dwordx4 v[180:183], v2, s[12:15], s43 offen nt
  s_waitcnt vmcnt(8)
  v_mfma_f32_16x16x32_bf16 v[24:27], v[148:151], v[8:11], 0
  v_add_f32_dpp v35, v16, v18 row_ror:8 row_mask:0xf bank_mask:0x4
  s_nop 1
  v_add_f32_dpp v35, v17, v35 row_ror:4 row_mask:0xf bank_mask:0x4
  s_nop 1
  v_add_f32_dpp v35, v19, v35 row_ror:12 row_mask:0xf bank_mask:0x4
  v_add_f32_dpp v34, v20, v23 row_ror:12 row_mask:0xf bank_mask:0x8
  s_nop 1
  v_add_f32_dpp v34, v21, v34 row_ror:8 row_mask:0xf bank_mask:0x8
  s_nop 1
  v_add_f32_dpp v34, v22, v34 row_ror:4 row_mask:0xf bank_mask:0x8
  s_nop 1
  v_add_f32_dpp v35, v24, v27 row_ror:12 row_mask:0xf bank_mask:0x8
  s_nop 1
  v_add_f32_dpp v35, v25, v35 row_ror:8 row_mask:0xf bank_mask:0x8
  s_nop 1
  v_add_f32_dpp v35, v26, v35 row_ror:4 row_mask:0xf bank_mask:0x8
  v_max3_f32 v4, v28, v29, v30
  v_max3_f32 v4, v4, v31, v32
  v_max3_f32 v4, v4, v33, v34
  v_max_f32 v4, v4, v35
  s_nop 1
  v_max_f32_dpp v5, v4, v4 row_ror:4 row_mask:0xf bank_mask:0xf
  s_nop 1
  v_max_f32_dpp v4, v5, v5 row_ror:8 row_mask:0xf bank_mask:0xf
  v_mov_b32 v5, v4
  s_nop 1
  v_permlane16_swap_b32 v5, v4
  v_max_f32 v4, v4, v5
  v_mov_b32 v5, v4
  s_nop 1
  v_permlane32_swap_b32 v5, v4
  v_max_f32 v4, v4, v5
  v_mul_f32 v4, s35, v4
  v_fma_f32 v28, v28, s35, -v4
  v_fma_f32 v29, v29, s35, -v4
  v_fma_f32 v30, v30, s35, -v4
  v_fma_f32 v31, v31, s35, -v4
  v_fma_f32 v32, v32, s35, -v4
  v_fma_f32 v33, v33, s35, -v4
  v_fma_f32 v34, v34, s35, -v4
  v_fma_f32 v35, v35, s35, -v4
  v_exp_f32 v28, v28
  v_exp_f32 v29, v29
  v_exp_f32 v30, v30
  v_exp_f32 v31, v31
  v_exp_f32 v32, v32
  v_exp_f32 v33, v33
  v_exp_f32 v34, v34
  v_exp_f32 v35, v35
  v_add_f32 v5, v28, v29
  v_add_f32 v8, v30, v31
  v_add_f32 v9, v32, v33
  v_add_f32 v10, v34, v35
  v_cvt_pk_bf16_f32 v36, v28, v29
  v_cvt_pk_bf16_f32 v37, v30, v31
  v_cvt_pk_bf16_f32 v38, v32, v33
  v_cvt_pk_bf16_f32 v39, v34, v35
  v_add_f32 v5, v5, v8
  v_add_f32 v9, v9, v10
  v_add_f32 v5, v5, v9
  s_nop 1
  v_add_f32_dpp v8, v5, v5 row_ror:4 row_mask:0xf bank_mask:0xf
  s_nop 1
  v_add_f32_dpp v5, v8, v8 row_ror:8 row_mask:0xf bank_mask:0xf
  v_mov_b32 v8, v5
  s_nop 1
  v_permlane16_swap_b32 v8, v5
  v_add_f32 v5, v5, v8
  v_mov_b32 v8, v5
  s_nop 1
  v_permlane32_swap_b32 v8, v5
  v_add_f32 v5, v5, v8
  s_mov_b64 exec, 0xf
  ds_write_b64 v3, v[4:5] offset:8192
  s_mov_b64 exec, -1
  v_mov_b32_dpp v80, v36 quad_perm:[0,1,2,3] row_mask:0xf bank_mask:0x1
  v_mov_b32_dpp v81, v36 row_ror:12 row_mask:0xf bank_mask:0x1
  v_mov_b32_dpp v82, v36 row_ror:8 row_mask:0xf bank_mask:0x1
  v_mov_b32_dpp v83, v36 row_ror:4 row_mask:0xf bank_mask:0x1
  v_mov_b32_dpp v84, v36 row_ror:4 row_mask:0xf bank_mask:0x2
  v_mov_b32_dpp v85, v36 quad_perm:[0,1,2,3] row_mask:0xf bank_mask:0x2
  v_mov_b32_dpp v86, v36 row_ror:12 row_mask:0xf bank_mask:0x2
  v_mov_b32_dpp v87, v36 row_ror:8 row_mask:0xf bank_mask:0x2
  v_mov_b32_dpp v88, v36 row_ror:8 row_mask:0xf bank_mask:0x4
  v_mov_b32_dpp v89, v36 row_ror:4 row_mask:0xf bank_mask:0x4
  v_mov_b32_dpp v90, v36 quad_perm:[0,1,2,3] row_mask:0xf bank_mask:0x4
  v_mov_b32_dpp v91, v36 row_ror:12 row_mask:0xf bank_mask:0x4
  v_mov_b32_dpp v92, v36 row_ror:12 row_mask:0xf bank_mask:0x8
  v_mov_b32_dpp v93, v36 row_ror:8 row_mask:0xf bank_mask:0x8
  v_mov_b32_dpp v94, v36 row_ror:4 row_mask:0xf bank_mask:0x8
  v_mov_b32_dpp v95, v36 quad_perm:[0,1,2,3] row_mask:0xf bank_mask:0x8
  v_mov_b32_dpp v96, v37 quad_perm:[0,1,2,3] row_mask:0xf bank_mask:0x1
  v_mov_b32_dpp v97, v37 row_ror:12 row_mask:0xf bank_mask:0x1
  v_mov_b32_dpp v98, v37 row_ror:8 row_mask:0xf bank_mask:0x1
  v_mov_b32_dpp v99, v37 row_ror:4 row_mask:0xf bank_mask:0x1
  v_mov_b32_dpp v100, v37 row_ror:4 row_mask:0xf bank_mask:0x2
  v_mov_b32_dpp v101, v37 quad_perm:[0,1,2,3] row_mask:0xf bank_mask:0x2
  v_mov_b32_dpp v102, v37 row_ror:12 row_mask:0xf bank_mask:0x2
  v_mov_b32_dpp v103, v37 row_ror:8 row_mask:0xf bank_mask:0x2
  v_mov_b32_dpp v104, v37 row_ror:8 row_mask:0xf bank_mask:0x4
  v_mov_b32_dpp v105, v37 row_ror:4 row_mask:0xf bank_mask:0x4
  v_mov_b32_dpp v106, v37 quad_perm:[0,1,2,3] row_mask:0xf bank_mask:0x4
  v_mov_b32_dpp v107, v37 row_ror:12 row_mask:0xf bank_mask:0x4
  v_mov_b32_dpp v108, v37 row_ror:12 row_mask:0xf bank_mask:0x8
  v_mov_b32_dpp v109, v37 row_ror:8 row_mask:0xf bank_mask:0x8
  v_mov_b32_dpp v110, v37 row_ror:4 row_mask:0xf bank_mask:0x8
  v_mov_b32_dpp v111, v37 quad_perm:[0,1,2,3] row_mask:0xf bank_mask:0x8
  v_mov_b32_dpp v112, v38 quad_perm:[0,1,2,3] row_mask:0xf bank_mask:0x1
  v_mov_b32_dpp v113, v38 row_ror:12 row_mask:0xf bank_mask:0x1
  v_mov_b32_dpp v114, v38 row_ror:8 row_mask:0xf bank_mask:0x1
  v_mov_b32_dpp v115, v38 row_ror:4 row_mask:0xf bank_mask:0x1
  v_mov_b32_dpp v116, v38 row_ror:4 row_mask:0xf bank_mask:0x2
  v_mov_b32_dpp v117, v38 quad_perm:[0,1,2,3] row_mask:0xf bank_mask:0x2
  v_mov_b32_dpp v118, v38 row_ror:12 row_mask:0xf bank_mask:0x2
  v_mov_b32_dpp v119, v38 row_ror:8 row_mask:0xf bank_mask:0x2
  v_mov_b32_dpp v120, v38 row_ror:8 row_mask:0xf bank_mask:0x4
  v_mov_b32_dpp v121, v38 row_ror:4 row_mask:0xf bank_mask:0x4
  v_mov_b32_dpp v122, v38 quad_perm:[0,1,2,3] row_mask:0xf bank_mask:0x4
  v_mov_b32_dpp v123, v38 row_ror:12 row_mask:0xf bank_mask:0x4
  v_mov_b32_dpp v124, v38 row_ror:12 row_mask:0xf bank_mask:0x8
  v_mov_b32_dpp v125, v38 row_ror:8 row_mask:0xf bank_mask:0x8
  v_mov_b32_dpp v126, v38 row_ror:4 row_mask:0xf bank_mask:0x8
  v_mov_b32_dpp v127, v38 quad_perm:[0,1,2,3] row_mask:0xf bank_mask:0x8
  v_mov_b32_dpp v128, v39 quad_perm:[0,1,2,3] row_mask:0xf bank_mask:0x1
  v_mov_b32_dpp v129, v39 row_ror:12 row_mask:0xf bank_mask:0x1
  v_mov_b32_dpp v130, v39 row_ror:8 row_mask:0xf bank_mask:0x1
  v_mov_b32_dpp v184, v39 row_ror:4 row_mask:0xf bank_mask:0x1
  v_mov_b32_dpp v132, v39 row_ror:4 row_mask:0xf bank_mask:0x2
  v_mov_b32_dpp v133, v39 quad_perm:[0,1,2,3] row_mask:0xf bank_mask:0x2
  v_mov_b32_dpp v134, v39 row_ror:12 row_mask:0xf bank_mask:0x2
  v_mov_b32_dpp v185, v39 row_ror:8 row_mask:0xf bank_mask:0x2
  v_mov_b32_dpp v136, v39 row_ror:8 row_mask:0xf bank_mask:0x4
  v_mov_b32_dpp v137, v39 row_ror:4 row_mask:0xf bank_mask:0x4
  v_mov_b32_dpp v138, v39 quad_perm:[0,1,2,3] row_mask:0xf bank_mask:0x4
  v_mov_b32_dpp v186, v39 row_ror:12 row_mask:0xf bank_mask:0x4
  v_mov_b32_dpp v140, v39 row_ror:12 row_mask:0xf bank_mask:0x8
  v_mov_b32_dpp v141, v39 row_ror:8 row_mask:0xf bank_mask:0x8
  v_mov_b32_dpp v142, v39 row_ror:4 row_mask:0xf bank_mask:0x8
  v_mov_b32_dpp v187, v39 quad_perm:[0,1,2,3] row_mask:0xf bank_mask:0x8
  s_xor_b32 s40, s28, 0x8000
  buffer_load_dwordx4 v[144:147], v2, s[12:15], s40 offen nt
  s_xor_b32 s41, s28, 0x9000
  buffer_load_dwordx4 v[148:151], v2, s[12:15], s41 offen nt
  s_waitcnt vmcnt(8)
  v_perm_b32 v48, v156, v152, s36
  v_perm_b32 v52, v156, v152, s37
  v_perm_b32 v56, v157, v153, s36
  v_perm_b32 v60, v157, v153, s37
  v_perm_b32 v64, v158, v154, s36
  v_perm_b32 v68, v158, v154, s37
  v_perm_b32 v72, v159, v155, s36
  v_perm_b32 v76, v159, v155, s37
  s_xor_b32 s42, s28, 0xa000
  buffer_load_dwordx4 v[152:155], v2, s[12:15], s42 offen nt
  s_xor_b32 s43, s28, 0xb000
  buffer_load_dwordx4 v[156:159], v2, s[12:15], s43 offen nt
  s_waitcnt vmcnt(8)
  v_perm_b32 v49, v164, v160, s36
  v_perm_b32 v53, v164, v160, s37
  v_perm_b32 v57, v165, v161, s36
  v_perm_b32 v61, v165, v161, s37
  v_perm_b32 v65, v166, v162, s36
  v_perm_b32 v69, v166, v162, s37
  v_perm_b32 v73, v167, v163, s36
  v_perm_b32 v77, v167, v163, s37
  s_xor_b32 s40, s28, 0xc000
  buffer_load_dwordx4 v[160:163], v2, s[12:15], s40 offen nt
  s_xor_b32 s41, s28, 0xd000
  buffer_load_dwordx4 v[164:167], v2, s[12:15], s41 offen nt
  s_waitcnt vmcnt(8)
  v_perm_b32 v50, v172, v168, s36
  v_perm_b32 v54, v172, v168, s37
  v_perm_b32 v58, v173, v169, s36
  v_perm_b32 v62, v173, v169, s37
  v_perm_b32 v66, v174, v170, s36
  v_perm_b32 v70, v174, v170, s37
  v_perm_b32 v74, v175, v171, s36
  v_perm_b32 v78, v175, v171, s37
  s_xor_b32 s42, s28, 0xe000
  buffer_load_dwordx4 v[168:171], v2, s[12:15], s42 offen nt
  s_xor_b32 s43, s28, 0xf000
  buffer_load_dwordx4 v[172:175], v2, s[12:15], s43 offen nt
  s_waitcnt vmcnt(8)
  v_perm_b32 v51, v180, v176, s36
  v_perm_b32 v55, v180, v176, s37
  v_perm_b32 v59, v181, v177, s36
  v_mfma_f32_16x16x32_bf16 v[40:43], v[80:83], v[48:51], 0
  v_perm_b32 v63, v181, v177, s37
  v_mfma_f32_16x16x32_bf16 v[44:47], v[80:83], v[52:55], 0
  v_perm_b32 v67, v182, v178, s36
  v_mfma_f32_16x16x32_bf16 v[40:43], v[84:87], v[56:59], v[40:43]
  v_perm_b32 v71, v182, v178, s37
  v_mfma_f32_16x16x32_bf16 v[44:47], v[84:87], v[60:63], v[44:47]
  v_perm_b32 v75, v183, v179, s36
  v_mfma_f32_16x16x32_bf16 v[40:43], v[88:91], v[64:67], v[40:43]
  v_perm_b32 v79, v183, v179, s37
  v_mfma_f32_16x16x32_bf16 v[44:47], v[88:91], v[68:71], v[44:47]
  v_mfma_f32_16x16x32_bf16 v[40:43], v[92:95], v[72:75], v[40:43]
  v_mfma_f32_16x16x32_bf16 v[44:47], v[92:95], v[76:79], v[44:47]
  s_xor_b32 s40, s28, 0x10000
  buffer_load_dwordx4 v[176:179], v2, s[12:15], s40 offen nt
  v_mov_b32 v22, 0
  buffer_load_dword v21, v22, s[20:23], s50 offen sc1
  s_xor_b32 s41, s28, 0x11000
  buffer_load_dwordx4 v[180:183], v2, s[12:15], s41 offen nt
  s_waitcnt vmcnt(9)
  v_perm_b32 v48, v148, v144, s36
  v_perm_b32 v52, v148, v144, s37
  v_perm_b32 v56, v149, v145, s36
  v_perm_b32 v60, v149, v145, s37
  v_perm_b32 v64, v150, v146, s36
  v_perm_b32 v68, v150, v146, s37
  v_perm_b32 v72, v151, v147, s36
  v_perm_b32 v76, v151, v147, s37
  s_xor_b32 s42, s28, 0x12000
  buffer_load_dwordx4 v[144:147], v2, s[12:15], s42 offen nt
  s_waitcnt lgkmcnt(0)
  s_barrier
  ds_read_b128 v[12:15], v7 offset:8192
  ds_read_b128 v[16:19], v7 offset:8208
  v_and_b32 v5, 63, v0
  v_lshlrev_b32 v4, 2, v5
  v_lshl_add_u32 v3, v6, 9, v4
  v_lshl_add_u32 v7, v6, 11, v4
  v_mul_u32_u24 v10, 0x280, v6
  v_lshl_add_u32 v9, v5, 3, v10
  v_and_b32 v4, 0x7c, v4
  v_add3_u32 v10, v10, v4, s56
  v_or_b32 v23, s29, v9
  v_or_b32 v20, s29, v10
  v_or_b32 v11, s30, v10
  v_and_b32 v4, 15, v0
  v_lshlrev_b32 v4, 4, v4
  v_bfe_u32 v5, v0, 4, 2
  v_lshl_or_b32 v4, v5, 2, v4
  v_lshl_or_b32 v1, v6, 8, v4
  s_waitcnt lgkmcnt(0)
  v_max3_f32 v26, v12, v14, v16
  v_max_f32 v26, v26, v18
  v_sub_f32 v12, v12, v26
  v_sub_f32 v14, v14, v26
  v_sub_f32 v16, v16, v26
  v_sub_f32 v18, v18, v26
  v_exp_f32 v12, v12
  v_exp_f32 v14, v14
  v_exp_f32 v16, v16
  v_exp_f32 v18, v18
  v_mul_f32 v4, v12, v13
  v_fmac_f32 v4, v14, v15
  v_fmac_f32 v4, v16, v17
  v_fmac_f32 v4, v18, v19
  v_rcp_f32 v5, v4
  v_log_f32 v4, v4
  s_nop 0
  v_mul_f32 v12, v12, v5
  v_mul_f32 v14, v14, v5
  v_mul_f32 v16, v16, v5
  v_mul_f32 v18, v18, v5
  v_add_f32 v26, v26, v4
  v_min_u32 v26, -2, v26
  buffer_store_dword v26, v11, s[24:27], s46 offen
  s_xor_b32 s43, s28, 0x13000
  buffer_load_dwordx4 v[148:151], v2, s[12:15], s43 offen nt
  s_waitcnt vmcnt(10)
  v_perm_b32 v49, v156, v152, s36
  v_perm_b32 v53, v156, v152, s37
  v_perm_b32 v57, v157, v153, s36
  v_perm_b32 v61, v157, v153, s37
  v_perm_b32 v65, v158, v154, s36
  v_perm_b32 v69, v158, v154, s37
  v_perm_b32 v73, v159, v155, s36
  v_perm_b32 v77, v159, v155, s37
  s_xor_b32 s40, s28, 0x14000
  buffer_load_dwordx4 v[152:155], v2, s[12:15], s40 offen nt
  s_xor_b32 s41, s28, 0x15000
  buffer_load_dwordx4 v[156:159], v2, s[12:15], s41 offen nt
  s_waitcnt vmcnt(10)
  v_perm_b32 v50, v164, v160, s36
  v_perm_b32 v54, v164, v160, s37
  v_perm_b32 v58, v165, v161, s36
  v_perm_b32 v62, v165, v161, s37
  v_perm_b32 v66, v166, v162, s36
  v_perm_b32 v70, v166, v162, s37
  v_perm_b32 v74, v167, v163, s36
  v_perm_b32 v78, v167, v163, s37
  s_xor_b32 s42, s28, 0x16000
  buffer_load_dwordx4 v[160:163], v2, s[12:15], s42 offen nt
  s_xor_b32 s43, s28, 0x17000
  buffer_load_dwordx4 v[164:167], v2, s[12:15], s43 offen nt
  s_waitcnt vmcnt(10)
  v_perm_b32 v51, v172, v168, s36
  v_perm_b32 v55, v172, v168, s37
  v_perm_b32 v59, v173, v169, s36
  v_mfma_f32_16x16x32_bf16 v[40:43], v[96:99], v[48:51], v[40:43]
  v_perm_b32 v63, v173, v169, s37
  v_mfma_f32_16x16x32_bf16 v[44:47], v[96:99], v[52:55], v[44:47]
  v_perm_b32 v67, v174, v170, s36
  v_mfma_f32_16x16x32_bf16 v[40:43], v[100:103], v[56:59], v[40:43]
  v_perm_b32 v71, v174, v170, s37
  v_mfma_f32_16x16x32_bf16 v[44:47], v[100:103], v[60:63], v[44:47]
  v_perm_b32 v75, v175, v171, s36
  v_mfma_f32_16x16x32_bf16 v[40:43], v[104:107], v[64:67], v[40:43]
  v_perm_b32 v79, v175, v171, s37
  v_mfma_f32_16x16x32_bf16 v[44:47], v[104:107], v[68:71], v[44:47]
  v_mfma_f32_16x16x32_bf16 v[40:43], v[108:111], v[72:75], v[40:43]
  v_mfma_f32_16x16x32_bf16 v[44:47], v[108:111], v[76:79], v[44:47]
  s_xor_b32 s40, s28, 0x18000
  buffer_load_dwordx4 v[168:171], v2, s[12:15], s40 offen nt
  s_xor_b32 s41, s28, 0x19000
  buffer_load_dwordx4 v[172:175], v2, s[12:15], s41 offen nt
  s_waitcnt vmcnt(9)
  v_perm_b32 v48, v180, v176, s36
  v_perm_b32 v52, v180, v176, s37
  v_perm_b32 v56, v181, v177, s36
  v_perm_b32 v60, v181, v177, s37
  v_perm_b32 v64, v182, v178, s36
  v_perm_b32 v68, v182, v178, s37
  v_perm_b32 v72, v183, v179, s36
  v_perm_b32 v76, v183, v179, s37
  s_xor_b32 s42, s28, 0x1a000
  buffer_load_dwordx4 v[176:179], v2, s[12:15], s42 offen nt
  v_readfirstlane_b32 s51, v21
  s_nop 0
  s_or_b32 s3, s51, s31
  s_and_b32 s3, s3, 0x4210
  s_cmp_eq_u32 s3, 0x4210
  s_cbranch_scc0 L_chkT
L_gotT:
  s_xor_b32 s55, s55, s51
  s_mov_b32 s53, 0
  s_bfe_u32 s3, s55, 0x50000
  s_cselect_b32 s3, 0x400000, 0
  s_or_b32 s53, s53, s3
  s_bfe_u32 s3, s55, 0x50005
  s_cselect_b32 s3, 0x2000000, 0
  s_or_b32 s53, s53, s3
  s_bfe_u32 s3, s55, 0x5000a
  s_cselect_b32 s3, 0x10000000, 0
  s_or_b32 s53, s53, s3
  s_bfe_u32 s3, s51, 0x5000f
  s_xor_b32 s52, s52, s3
  s_mov_b32 s54, s53
  buffer_load_dword v34, v20, s[24:27], s47 offen nt
  buffer_load_dword v36, v20, s[24:27], s48 offen nt
  buffer_load_dword v38, v20, s[24:27], s49 offen nt
  s_xor_b32 s43, s28, 0x1b000
  buffer_load_dwordx4 v[180:183], v2, s[12:15], s43 offen nt
  s_waitcnt vmcnt(11)
  v_perm_b32 v49, v148, v144, s36
  v_perm_b32 v53, v148, v144, s37
  v_perm_b32 v57, v149, v145, s36
  v_perm_b32 v61, v149, v145, s37
  v_perm_b32 v65, v150, v146, s36
  v_perm_b32 v69, v150, v146, s37
  v_perm_b32 v73, v151, v147, s36
  v_perm_b32 v77, v151, v147, s37
  s_xor_b32 s40, s28, 0x1c000
  buffer_load_dwordx4 v[144:147], v2, s[12:15], s40 offen nt
  s_xor_b32 s41, s28, 0x1d000
  buffer_load_dwordx4 v[148:151], v2, s[12:15], s41 offen nt
  s_waitcnt vmcnt(11)
  v_perm_b32 v50, v156, v152, s36
  v_perm_b32 v54, v156, v152, s37
  v_perm_b32 v58, v157, v153, s36
  v_perm_b32 v62, v157, v153, s37
  v_perm_b32 v66, v158, v154, s36
  v_perm_b32 v70, v158, v154, s37
  v_perm_b32 v74, v159, v155, s36
  v_perm_b32 v78, v159, v155, s37
  s_xor_b32 s42, s28, 0x1e000
  buffer_load_dwordx4 v[152:155], v2, s[12:15], s42 offen nt
  s_xor_b32 s43, s28, 0x1f000
  buffer_load_dwordx4 v[156:159], v2, s[12:15], s43 offen nt
  s_waitcnt vmcnt(11)
  v_perm_b32 v51, v164, v160, s36
  v_perm_b32 v55, v164, v160, s37
  v_perm_b32 v59, v165, v161, s36
  v_mfma_f32_16x16x32_bf16 v[40:43], v[112:115], v[48:51], v[40:43]
  v_perm_b32 v63, v165, v161, s37
  v_mfma_f32_16x16x32_bf16 v[44:47], v[112:115], v[52:55], v[44:47]
  v_perm_b32 v67, v166, v162, s36
  v_mfma_f32_16x16x32_bf16 v[40:43], v[116:119], v[56:59], v[40:43]
  v_perm_b32 v71, v166, v162, s37
  v_mfma_f32_16x16x32_bf16 v[44:47], v[116:119], v[60:63], v[44:47]
  v_perm_b32 v75, v167, v163, s36
  v_mfma_f32_16x16x32_bf16 v[40:43], v[120:123], v[64:67], v[40:43]
  v_perm_b32 v79, v167, v163, s37
  v_mfma_f32_16x16x32_bf16 v[44:47], v[120:123], v[68:71], v[44:47]
  v_mfma_f32_16x16x32_bf16 v[40:43], v[124:127], v[72:75], v[40:43]
  v_mfma_f32_16x16x32_bf16 v[44:47], v[124:127], v[76:79], v[44:47]
  buffer_load_dwordx2 v[28:29], v23, s[24:27], s47 offen nt
  buffer_load_dwordx2 v[30:31], v23, s[24:27], s48 offen nt
  buffer_load_dwordx2 v[32:33], v23, s[24:27], s49 offen nt
  s_waitcnt vmcnt(12)
  v_perm_b32 v48, v172, v168, s36
  v_perm_b32 v52, v172, v168, s37
  v_perm_b32 v56, v173, v169, s36
  v_perm_b32 v60, v173, v169, s37
  v_perm_b32 v64, v174, v170, s36
  v_perm_b32 v68, v174, v170, s37
  v_perm_b32 v72, v175, v171, s36
  v_perm_b32 v76, v175, v171, s37
  s_waitcnt vmcnt(7)
  v_perm_b32 v49, v180, v176, s36
  v_perm_b32 v53, v180, v176, s37
  v_perm_b32 v57, v181, v177, s36
  v_perm_b32 v61, v181, v177, s37
  v_perm_b32 v65, v182, v178, s36
  v_perm_b32 v69, v182, v178, s37
  v_perm_b32 v73, v183, v179, s36
  v_perm_b32 v77, v183, v179, s37
  v_max3_u32 v4, v34, v36, v38
  v_cmp_eq_u32 vcc, -1, v4
  v_max3_f32 v4, v34, v36, v38
  v_max_f32 v4, v4, v26
  v_sub_f32 v8, v26, v4
  v_sub_f32 v34, v34, v4
  v_sub_f32 v36, v36, v4
  v_sub_f32 v38, v38, v4
  v_exp_f32 v8, v8
  v_exp_f32 v34, v34
  v_exp_f32 v36, v36
  v_exp_f32 v38, v38
  v_add_f32 v4, v8, v34
  v_add_f32 v5, v36, v38
  v_add_f32 v4, v4, v5
  v_rcp_f32 v4, v4
  s_nop 0
  v_mul_f32 v8, v8, v4
  v_mul_f32 v34, v34, v4
  v_mul_f32 v36, v36, v4
  v_mul_f32 v38, v38, v4
  s_or_b32 s54, s54, vcc_lo
  s_or_b32 s54, s54, vcc_hi
  s_waitcnt vmcnt(5)
  v_perm_b32 v50, v148, v144, s36
  v_perm_b32 v54, v148, v144, s37
  v_perm_b32 v58, v149, v145, s36
  v_mfma_f32_16x16x32_bf16 v[40:43], v[128:131], v[48:51], v[40:43]
  v_perm_b32 v62, v149, v145, s37
  v_mfma_f32_16x16x32_bf16 v[44:47], v[128:131], v[52:55], v[44:47]
  v_perm_b32 v66, v150, v146, s36
  v_mfma_f32_16x16x32_bf16 v[40:43], v[132:135], v[56:59], v[40:43]
  v_perm_b32 v70, v150, v146, s37
  v_mfma_f32_16x16x32_bf16 v[44:47], v[132:135], v[60:63], v[44:47]
  v_perm_b32 v74, v151, v147, s36
  v_mfma_f32_16x16x32_bf16 v[40:43], v[136:139], v[64:67], v[40:43]
  v_perm_b32 v78, v151, v147, s37
  v_mfma_f32_16x16x32_bf16 v[44:47], v[136:139], v[68:71], v[44:47]
  v_mfma_f32_16x16x32_bf16 v[40:43], v[140:143], v[72:75], v[40:43]
  v_mfma_f32_16x16x32_bf16 v[44:47], v[140:143], v[76:79], v[44:47]
  s_waitcnt vmcnt(3)
  v_perm_b32 v188, v156, v152, s36
  v_perm_b32 v189, v157, v153, s36
  v_perm_b32 v190, v158, v154, s36
  v_perm_b32 v191, v159, v155, s36
  v_perm_b32 v192, v156, v152, s37
  v_perm_b32 v193, v157, v153, s37
  v_mfma_f32_16x16x32_bf16 v[40:43], v[184:187], v[188:191], v[40:43]
  v_perm_b32 v194, v158, v154, s37
  v_perm_b32 v195, v159, v155, s37
  s_nop 1
  v_mfma_f32_16x16x32_bf16 v[44:47], v[184:187], v[192:195], v[44:47]
  s_nop 7
  ds_write2st64_b32 v3, v40, v44 offset0:0 offset1:1
  ds_write2st64_b32 v3, v41, v45 offset0:8 offset1:9
  ds_write2st64_b32 v3, v42, v46 offset0:16 offset1:17
  ds_write2st64_b32 v3, v43, v47 offset0:24 offset1:25
  s_cmp_eq_u32 s33, 3
  s_waitcnt lgkmcnt(0)
  s_barrier
  ds_read2st64_b32 v[48:49], v7 offset0:0 offset1:1
  ds_read2st64_b32 v[50:51], v7 offset0:2 offset1:3
  ds_read2st64_b32 v[52:53], v7 offset0:4 offset1:5
  ds_read2st64_b32 v[54:55], v7 offset0:6 offset1:7
  s_cbranch_scc0 L_tailP
  buffer_load_dwordx2 v[28:29], v23, s[24:27], s47 offen sc1
  buffer_load_dwordx2 v[30:31], v23, s[24:27], s48 offen sc1
  buffer_load_dwordx2 v[32:33], v23, s[24:27], s49 offen sc1
  s_lshl_b32 s44, 1, 14
  s_cmp_lg_u32 s54, 0
  s_waitcnt lgkmcnt(3)
  v_pk_mul_f32 v[24:25], v[48:49], v[12:13] op_sel_hi:[1,0]
  s_waitcnt lgkmcnt(2)
  v_pk_fma_f32 v[24:25], v[50:51], v[14:15], v[24:25] op_sel_hi:[1,0,1]
  s_waitcnt lgkmcnt(1)
  v_pk_fma_f32 v[24:25], v[52:53], v[16:17], v[24:25] op_sel_hi:[1,0,1]
  s_waitcnt lgkmcnt(0)
  v_pk_fma_f32 v[24:25], v[54:55], v[18:19], v[24:25] op_sel_hi:[1,0,1]
  s_cbranch_scc1 L_slow
L_go:
  v_pk_mul_f32 v[48:49], v[24:25], v[8:9] op_sel_hi:[1,0]
L_chk:
  s_waitcnt vmcnt(0)
  v_max3_u32 v4, v28, v29, v30
  v_max3_u32 v5, v31, v32, v33
  v_max_u32 v4, v4, v5
  v_cmp_eq_u32 vcc, -1, v4
  v_pk_fma_f32 v[50:51], v[28:29], v[34:35], v[48:49] op_sel_hi:[1,0,1]
  v_pk_fma_f32 v[50:51], v[30:31], v[36:37], v[50:51] op_sel_hi:[1,0,1]
  v_pk_fma_f32 v[50:51], v[32:33], v[38:39], v[50:51] op_sel_hi:[1,0,1]
  v_cvt_pk_bf16_f32 v4, v50, v51
  s_cbranch_vccnz L_again
  buffer_store_dword v4, v1, s[16:19], s34 offen
  s_endpgm
L_again:
  buffer_load_dwordx2 v[28:29], v23, s[24:27], s47 offen sc1
  buffer_load_dwordx2 v[30:31], v23, s[24:27], s48 offen sc1
  buffer_load_dwordx2 v[32:33], v23, s[24:27], s49 offen sc1
  s_sub_u32 s44, s44, 1
  s_cbranch_scc0 L_chk
  s_endpgm
L_tailP:
  s_cmp_eq_u32 s52, 0
  s_waitcnt lgkmcnt(3)
  v_pk_mul_f32 v[24:25], v[48:49], v[12:13] op_sel_hi:[1,0]
  s_waitcnt lgkmcnt(2)
  v_pk_fma_f32 v[24:25], v[50:51], v[14:15], v[24:25] op_sel_hi:[1,0,1]
  s_waitcnt lgkmcnt(1)
  v_pk_fma_f32 v[24:25], v[52:53], v[16:17], v[24:25] op_sel_hi:[1,0,1]
  s_waitcnt lgkmcnt(0)
  v_pk_fma_f32 v[24:25], v[54:55], v[18:19], v[24:25] op_sel_hi:[1,0,1]
  v_min_u32 v24, -2, v24
  v_min_u32 v25, -2, v25
  buffer_store_dwordx2 v[24:25], v9, s[24:27], s46 offen
  s_cbranch_scc1 L_end
L_far:
  s_add_u32 s46, s46, 0x100000
  buffer_store_dwordx2 v[24:25], v9, s[24:27], s46 offen sc1
  buffer_store_dword v26, v11, s[24:27], s46 offen sc1
  s_mul_i32 s3, s33, 3
  s_lshl_b32 s3, 0x100000, s3
  v_mov_b32 v4, s3
  s_mov_b64 exec, 1
  s_waitcnt vmcnt(0)
  buffer_atomic_add v4, v22, s[20:23], s50 offen
  s_endpgm
L_slow:
  s_and_b32 s3, s51, s53
  s_cmp_eq_u32 s3, s53
  s_cbranch_scc1 L_slow1
  buffer_load_dword v21, v22, s[20:23], s50 offen sc1
  s_sub_u32 s44, s44, 1
  s_cbranch_scc1 L_end
  s_waitcnt vmcnt(0)
  v_readfirstlane_b32 s51, v21
  s_branch L_slow
L_slow1:
  s_bitcmp1_b32 s53, 22
  s_cselect_b32 s3, 0x100000, 0
  s_add_u32 s47, s47, s3
  s_bitcmp1_b32 s53, 25
  s_cselect_b32 s3, 0x100000, 0
  s_add_u32 s48, s48, s3
  s_bitcmp1_b32 s53, 28
  s_cselect_b32 s3, 0x100000, 0
  s_add_u32 s49, s49, s3
L_slow2:
  buffer_load_dword v34, v20, s[24:27], s47 offen sc1
  buffer_load_dword v36, v20, s[24:27], s48 offen sc1
  buffer_load_dword v38, v20, s[24:27], s49 offen sc1
  s_sub_u32 s44, s44, 1
  s_cbranch_scc1 L_end
  s_waitcnt vmcnt(0)
  v_max3_u32 v4, v34, v36, v38
  v_cmp_eq_u32 vcc, -1, v4
  s_cbranch_vccnz L_slow2
  v_max3_f32 v4, v34, v36, v38
  v_max_f32 v4, v4, v26
  v_sub_f32 v8, v26, v4
  v_sub_f32 v34, v34, v4
  v_sub_f32 v36, v36, v4
  v_sub_f32 v38, v38, v4
  v_exp_f32 v8, v8
  v_exp_f32 v34, v34
  v_exp_f32 v36, v36
  v_exp_f32 v38, v38
  v_add_f32 v4, v8, v34
  v_add_f32 v5, v36, v38
  v_add_f32 v4, v4, v5
  v_rcp_f32 v4, v4
  s_nop 0
  v_mul_f32 v8, v8, v4
  v_mul_f32 v34, v34, v4
  v_mul_f32 v36, v36, v4
  v_mul_f32 v38, v38, v4
  buffer_load_dwordx2 v[28:29], v23, s[24:27], s47 offen sc1
  buffer_load_dwordx2 v[30:31], v23, s[24:27], s48 offen sc1
  buffer_load_dwordx2 v[32:33], v23, s[24:27], s49 offen sc1
  s_branch L_go
L_chkT:
  s_lshl_b32 s44, 1, 14
L_chkT1:
  buffer_load_dword v21, v22, s[20:23], s50 offen sc1
  s_sub_u32 s44, s44, 1
  s_cbranch_scc1 L_end
  s_waitcnt vmcnt(0)
  v_readfirstlane_b32 s51, v21
  s_nop 0
  s_and_b32 s3, s51, 0x4210
  s_cmp_eq_u32 s3, 0x4210
  s_cbranch_scc1 L_gotT
  s_branch L_chkT1
L_fin:
L_end:
  s_endpgm
L_helper:
  s_load_dwordx2 s[20:21], s[0:1], 32
  s_load_dwordx2 s[24:25], s[0:1], 40
  s_movk_i32 s22, 0x100
  s_lshl_b32 s23, 1, 17
  s_lshl_b32 s26, 1, 28
  s_mov_b32 s27, s23
  s_lshl_b32 s46, s32, 14
  s_lshl_b32 s3, s33, 12
  s_or_b32 s46, s46, s3
  s_add_u32 s46, s46, 0xfe00000
  s_lshl_b32 s50, s32, 2
  s_getreg_b32 s52, hwreg(HW_REG_XCC_ID, 0, 4)
  s_or_b32 s52, s52, 16
  s_mul_i32 s3, s33, 5
  s_lshl_b32 s52, s52, s3
  v_and_b32 v2, 63, v0
  v_lshlrev_b32 v2, 4, v2
  v_lshlrev_b32 v10, 2, v2
  v_mov_b32 v9, 0
  v_mov_b32 v8, s52
  v_mov_b32 v12, -1
  v_mov_b32 v13, -1
  v_mov_b32 v14, -1
  v_mov_b32 v15, -1
  s_cmp_eq_u32 s33, 3
  s_waitcnt lgkmcnt(0)
  s_cbranch_scc1 L_helpF
  s_barrier
  buffer_store_dwordx4 v[12:15], v2, s[24:27], s46 offen offset:0
  buffer_store_dwordx4 v[12:15], v2, s[24:27], s46 offen offset:1024
  s_mov_b32 exec_hi, 0
  buffer_store_dwordx4 v[12:15], v2, s[24:27], s46 offen offset:2048
  s_waitcnt vmcnt(0)
L_helpF:
  s_mov_b64 exec, 1
  buffer_atomic_add v8, v9, s[20:23], s50 offen
  s_endpgm
.section .rodata,"a"
.p2align 6
.amdhsa_kernel standalone__gqa_softmax__sampling_kernel
  .amdhsa_next_free_vgpr 200
  .amdhsa_next_free_sgpr 102
  .amdhsa_accum_offset 200
  .amdhsa_group_segment_fixed_size 0
  .amdhsa_kernarg_size 48
  .amdhsa_user_sgpr_count 2
  .amdhsa_user_sgpr_kernarg_segment_ptr 1
  .amdhsa_system_sgpr_workgroup_id_x 1
.end_amdhsa_kernel
```
